```python
import torch

def _softmax(x, axis=-1):
    return torch.softmax(x, dim=axis)
def _gelu(x):
    return torch.nn.functional.gelu(x, approximate="tanh")
def _silu(x):
    return torch.nn.functional.silu(x)
def _sigmoid(x):
    return torch.sigmoid(x)
def _layernorm(x, axis=-1, eps=1e-5):
    m = x.mean(dim=axis, keepdim=True)
    v = x.var(dim=axis, keepdim=True, unbiased=False)
    return (x - m) / torch.sqrt(v + eps)
def _scatter_add(tgt, idx, src, axis=0):
    return tgt.clone().index_add_(axis, idx, src)
def _segment_sum(src, seg, n):
    out = torch.zeros((n,) + src.shape[1:], dtype=src.dtype)
    return out.index_add_(0, seg, src)
def _pad(x, pw):
    flat = tuple(v for pair in reversed(pw) for v in pair)
    return torch.nn.functional.pad(x, flat)

kernel_name = 'standalone__edge_featured_mpnn_egc__graph'

def setup_inputs():

    _w = (lambda a: (lambda t: t.to(torch.bfloat16) if t.is_floating_point() else t)(torch.as_tensor(a)))
    N, deg, D, De = 12500, 64, 64, max(0, 1)
    E = N * deg
    return {
        "x": _w((lambda *s: torch.randn(*s, dtype=torch.bfloat16) * 0.2)(N, D)),
        "e_attr": _w((lambda *s: torch.randn(*s, dtype=torch.bfloat16) * 0.2)(E, De)),
        "src": _w((lambda lo, hi, *s: torch.randint(lo, hi, s))(0, N, E).to(torch.int64)),
        "dst": _w((lambda lo, hi, *s: torch.randint(lo, hi, s))(0, N, E).to(torch.int64)),
        "u_w": _w((lambda *s: torch.randn(*s, dtype=torch.bfloat16) * 0.05)(D, D)),
        "v_w": _w((lambda *s: torch.randn(*s, dtype=torch.bfloat16) * 0.05)(D, D)),
        "g_w": _w((lambda *s: torch.randn(*s, dtype=torch.bfloat16) * 0.2)(2 * D + De, D)),
    }

def reference(x, e_attr, src, dst, u_w, v_w, g_w):
    N, D = x.shape
    g_in = torch.concatenate([x[dst], x[src], e_attr], axis=-1)
    eta = _sigmoid(g_in @ g_w)
    hv = x @ v_w
    msg = eta * hv[src]
    agg = _segment_sum(msg, dst, N)
    return _silu(x @ u_w + agg)
```

```asm
; @launch kernel=mpnn_k1_kernel grid=(348,1,1) block=(512,1,1) lds=36864
; @launch kernel=mpnn_k2_kernel grid=(256,1,1) block=(1024,1,1) lds=163840
.amdgcn_target "amdgcn-amd-amdhsa--gfx950"
.text
.globl mpnn_k1_kernel
.p2align 8
.type mpnn_k1_kernel,@function
mpnn_k1_kernel:
  s_cmp_ge_u32 s2, 348
  s_cbranch_scc1 K1_END
  s_load_dwordx8 s[8:15], s[0:1], 0
  s_load_dwordx8 s[16:23], s[0:1], 32
  s_load_dwordx2 s[24:25], s[0:1], 72
  s_cmp_ge_u32 s2, 250
  s_cbranch_scc1 K1_GEMM
  v_lshlrev_b32 v1, 4, v0
  v_lshlrev_b32 v2, 3, v0
  v_lshlrev_b32 v3, 2, v0
  v_mov_b32 v4, 0
  ds_write_b32 v3, v4 offset:0
  s_mul_i32 s50, s2, 12800
  s_mul_i32 s54, s2, 6400
  s_add_u32 s51, s50, 6400
  s_add_u32 s55, s54, 3200
  s_mov_b32 s58, 21400
  s_mov_b32 s59, -49
  v_cmp_gt_u32 vcc, 400, v0
  s_waitcnt lgkmcnt(0)
  s_mov_b32 s28, s14
  s_and_b32 s29, s15, 0xffff
  s_mov_b32 s30, 3200000
  s_mov_b32 s31, 0x00020000
  s_mov_b32 s32, s12
  s_and_b32 s33, s13, 0xffff
  s_mov_b32 s34, 3200000
  s_mov_b32 s35, 0x00020000
  s_mov_b32 s36, s10
  s_and_b32 s37, s11, 0xffff
  s_mov_b32 s38, 1600000
  s_mov_b32 s39, 0x00020000
  s_and_saveexec_b64 s[62:63], vcc
  s_cbranch_execz K1_P_L0
  buffer_load_dwordx4 v[8:11], v1, s[28:31], s50 offen
  buffer_load_dwordx4 v[12:15], v1, s[28:31], s51 offen
  buffer_load_dwordx4 v[16:19], v1, s[32:35], s50 offen
  buffer_load_dwordx4 v[20:23], v1, s[32:35], s51 offen
  buffer_load_dwordx2 v[24:25], v2, s[36:39], s54 offen
  buffer_load_dwordx2 v[26:27], v2, s[36:39], s55 offen
K1_P_L0:
  s_mul_i32 s60, s2, 25600
  s_add_u32 s60, s60, 12582912
  s_add_u32 s40, s24, s60
  s_addc_u32 s41, s25, 0
  s_and_b32 s41, s41, 0xffff
  s_mov_b32 s42, 25600
  s_mov_b32 s43, 0x00020000
  s_add_u32 s44, s24, 20971520
  s_addc_u32 s45, s25, 0
  s_and_b32 s45, s45, 0xffff
  s_mov_b32 s46, 263168
  s_mov_b32 s47, 0x00020000
  v_mov_b32 v5, 1
  s_mov_b32 s61, 0xffff0000
  s_barrier
  s_waitcnt vmcnt(4)
  v_mul_u32_u24 v6, s58, v8
  v_lshrrev_b32 v6, 20, v6
  v_mad_i32_i24 v45, v6, s59, v8
  v_and_b32 v7, 7, v6
  v_lshrrev_b32 v6, 3, v6
  v_lshl_or_b32 v6, v7, 5, v6
  v_lshlrev_b32 v28, 2, v6
  ds_add_rtn_u32 v36, v28, v5 offset:0
  v_mul_u32_u24 v6, s58, v9
  v_lshrrev_b32 v6, 20, v6
  v_mad_i32_i24 v47, v6, s59, v9
  v_and_b32 v7, 7, v6
  v_lshrrev_b32 v6, 3, v6
  v_lshl_or_b32 v6, v7, 5, v6
  v_lshlrev_b32 v29, 2, v6
  ds_add_rtn_u32 v37, v29, v5 offset:0
  v_mul_u32_u24 v6, s58, v10
  v_lshrrev_b32 v6, 20, v6
  v_mad_i32_i24 v49, v6, s59, v10
  v_and_b32 v7, 7, v6
  v_lshrrev_b32 v6, 3, v6
  v_lshl_or_b32 v6, v7, 5, v6
  v_lshlrev_b32 v30, 2, v6
  ds_add_rtn_u32 v38, v30, v5 offset:0
  v_mul_u32_u24 v6, s58, v11
  v_lshrrev_b32 v6, 20, v6
  v_mad_i32_i24 v51, v6, s59, v11
  v_and_b32 v7, 7, v6
  v_lshrrev_b32 v6, 3, v6
  v_lshl_or_b32 v6, v7, 5, v6
  v_lshlrev_b32 v31, 2, v6
  ds_add_rtn_u32 v39, v31, v5 offset:0
  v_mul_u32_u24 v6, s58, v12
  v_lshrrev_b32 v6, 20, v6
  v_mad_i32_i24 v53, v6, s59, v12
  v_and_b32 v7, 7, v6
  v_lshrrev_b32 v6, 3, v6
  v_lshl_or_b32 v6, v7, 5, v6
  v_lshlrev_b32 v32, 2, v6
  ds_add_rtn_u32 v40, v32, v5 offset:0
  v_mul_u32_u24 v6, s58, v13
  v_lshrrev_b32 v6, 20, v6
  v_mad_i32_i24 v55, v6, s59, v13
  v_and_b32 v7, 7, v6
  v_lshrrev_b32 v6, 3, v6
  v_lshl_or_b32 v6, v7, 5, v6
  v_lshlrev_b32 v33, 2, v6
  ds_add_rtn_u32 v41, v33, v5 offset:0
  v_mul_u32_u24 v6, s58, v14
  v_lshrrev_b32 v6, 20, v6
  v_mad_i32_i24 v57, v6, s59, v14
  v_and_b32 v7, 7, v6
  v_lshrrev_b32 v6, 3, v6
  v_lshl_or_b32 v6, v7, 5, v6
  v_lshlrev_b32 v34, 2, v6
  ds_add_rtn_u32 v42, v34, v5 offset:0
  v_mul_u32_u24 v6, s58, v15
  v_lshrrev_b32 v6, 20, v6
  v_mad_i32_i24 v59, v6, s59, v15
  v_and_b32 v7, 7, v6
  v_lshrrev_b32 v6, 3, v6
  v_lshl_or_b32 v6, v7, 5, v6
  v_lshlrev_b32 v35, 2, v6
  ds_add_rtn_u32 v43, v35, v5 offset:0
  s_waitcnt lgkmcnt(0)
  s_barrier
  s_waitcnt vmcnt(0)
  v_lshl_or_b32 v44, v24, 16, v16
  v_and_or_b32 v46, v24, s61, v17
  v_lshl_or_b32 v48, v25, 16, v18
  v_and_or_b32 v50, v25, s61, v19
  v_lshl_or_b32 v52, v26, 16, v20
  v_and_or_b32 v54, v26, s61, v21
  v_lshl_or_b32 v56, v27, 16, v22
  v_and_or_b32 v58, v27, s61, v23
  s_mov_b64 exec, s[62:63]
  v_cmp_gt_u32 vcc, 64, v0
  s_and_saveexec_b64 s[64:65], vcc
  s_cbranch_execz K1_P_SCANDONE
  ds_read_b128 v[60:63], v1 offset:0
  s_waitcnt lgkmcnt(0)
  v_add_u32 v65, v60, v61
  v_add_u32 v66, v65, v62
  v_add_u32 v67, v66, v63
  v_mov_b32 v68, v67
  s_nop 1
  v_add_u32_dpp v68, v68, v68 row_shr:1 row_mask:0xf bank_mask:0xf
  s_nop 1
  v_add_u32_dpp v68, v68, v68 row_shr:2 row_mask:0xf bank_mask:0xf
  s_nop 1
  v_add_u32_dpp v68, v68, v68 row_shr:4 row_mask:0xf bank_mask:0xf
  s_nop 1
  v_add_u32_dpp v68, v68, v68 row_shr:8 row_mask:0xf bank_mask:0xf
  s_nop 1
  v_add_u32_dpp v68, v68, v68 row_bcast:15 row_mask:0xa bank_mask:0xf
  s_nop 1
  v_add_u32_dpp v68, v68, v68 row_bcast:31 row_mask:0xc bank_mask:0xf
  s_nop 1
  v_sub_u32 v68, v68, v67
  v_add_u32 v69, v68, v60
  v_add_u32 v70, v68, v65
  v_add_u32 v71, v68, v66
  ds_write_b128 v1, v[68:71] offset:1024
  v_lshlrev_b32 v64, 12, v0
  s_lshl_b32 s66, s2, 2
  buffer_store_dword v68, v64, s[44:47], s66 offen offset:0 sc1
  buffer_store_dword v69, v64, s[44:47], s66 offen offset:1024 sc1
  buffer_store_dword v70, v64, s[44:47], s66 offen offset:2048 sc1
  buffer_store_dword v71, v64, s[44:47], s66 offen offset:3072 sc1
  v_mov_b32 v72, 3200
  v_mov_b32 v73, 262144
  buffer_store_dword v72, v73, s[44:47], s66 offen sc1
K1_P_SCANDONE:
  s_mov_b64 exec, s[64:65]
  v_cmp_gt_u32 vcc, 400, v0
  s_and_saveexec_b64 s[62:63], vcc
  s_waitcnt lgkmcnt(0)
  s_barrier
  ds_read_b32 v8, v28 offset:1024
  ds_read_b32 v9, v29 offset:1024
  ds_read_b32 v10, v30 offset:1024
  ds_read_b32 v11, v31 offset:1024
  ds_read_b32 v12, v32 offset:1024
  ds_read_b32 v13, v33 offset:1024
  ds_read_b32 v14, v34 offset:1024
  ds_read_b32 v15, v35 offset:1024
  s_waitcnt lgkmcnt(0)
  v_add_u32 v6, v8, v36
  v_lshlrev_b32 v6, 3, v6
  ds_write_b64 v6, v[44:45] offset:2048
  v_add_u32 v6, v9, v37
  v_lshlrev_b32 v6, 3, v6
  ds_write_b64 v6, v[46:47] offset:2048
  v_add_u32 v6, v10, v38
  v_lshlrev_b32 v6, 3, v6
  ds_write_b64 v6, v[48:49] offset:2048
  v_add_u32 v6, v11, v39
  v_lshlrev_b32 v6, 3, v6
  ds_write_b64 v6, v[50:51] offset:2048
  v_add_u32 v6, v12, v40
  v_lshlrev_b32 v6, 3, v6
  ds_write_b64 v6, v[52:53] offset:2048
  v_add_u32 v6, v13, v41
  v_lshlrev_b32 v6, 3, v6
  ds_write_b64 v6, v[54:55] offset:2048
  v_add_u32 v6, v14, v42
  v_lshlrev_b32 v6, 3, v6
  ds_write_b64 v6, v[56:57] offset:2048
  v_add_u32 v6, v15, v43
  v_lshlrev_b32 v6, 3, v6
  ds_write_b64 v6, v[58:59] offset:2048
  s_mov_b64 exec, s[62:63]
  s_waitcnt lgkmcnt(0)
  s_barrier
  ds_read_b128 v[8:11], v1 offset:2048
  ds_read_b128 v[12:15], v1 offset:10240
  ds_read_b128 v[16:19], v1 offset:18432
  ds_read_b128 v[20:23], v1 offset:26624
  v_add_u32 v2, 0x2000, v1
  v_add_u32 v3, 0x4000, v1
  v_add_u32 v4, 0x6000, v1
  s_waitcnt lgkmcnt(3)
  buffer_store_dwordx4 v[8:11], v1, s[40:43], 0 offen sc1
  s_waitcnt lgkmcnt(2)
  buffer_store_dwordx4 v[12:15], v2, s[40:43], 0 offen sc1
  s_waitcnt lgkmcnt(1)
  buffer_store_dwordx4 v[16:19], v3, s[40:43], 0 offen sc1
  s_waitcnt lgkmcnt(0)
  buffer_store_dwordx4 v[20:23], v4, s[40:43], 0 offen sc1
  s_endpgm
K1_GEMM:
  s_sub_u32 s3, s2, 250
  v_lshrrev_b32 v1, 6, v0
  s_nop 0
  v_readfirstlane_b32 s5, v1
  v_and_b32 v2, 63, v0
  v_and_b32 v3, 31, v2
  v_lshrrev_b32 v4, 5, v2
  v_lshlrev_b32 v10, 4, v0
  s_and_b32 s6, s5, 1
  s_lshr_b32 s26, s5, 1
  s_lshl_b32 s4, s3, 2
  s_add_u32 s4, s4, s26
  s_lshl_b32 s4, s4, 5
  s_waitcnt lgkmcnt(0)
  s_mov_b32 s28, s20
  s_and_b32 s29, s21, 0xffff
  s_mov_b32 s30, 16384
  s_mov_b32 s31, 0x00020000
  s_mov_b32 s32, s18
  s_and_b32 s33, s19, 0xffff
  s_mov_b32 s34, 8192
  s_mov_b32 s35, 0x00020000
  s_mov_b32 s36, s8
  s_and_b32 s37, s9, 0xffff
  s_mov_b32 s38, 1600000
  s_mov_b32 s39, 0x00020000
  s_mov_b32 s26, 8192
  buffer_load_dwordx4 v[32:35], v10, s[28:31], s26 offen
  buffer_load_dwordx4 v[36:39], v10, s[32:35], 0 offen
  v_add_u32 v7, s4, v3
  v_lshlrev_b32 v7, 7, v7
  v_lshl_add_u32 v7, v4, 4, v7
  buffer_load_dwordx4 v[16:19], v7, s[36:39], 0 offen offset:0
  buffer_load_dwordx4 v[20:23], v7, s[36:39], 0 offen offset:32
  buffer_load_dwordx4 v[24:27], v7, s[36:39], 0 offen offset:64
  buffer_load_dwordx4 v[28:31], v7, s[36:39], 0 offen offset:96
  s_add_u32 s40, s24, 0
  s_addc_u32 s41, s25, 0
  s_and_b32 s41, s41, 0xffff
  s_mov_b32 s42, 3211264
  s_mov_b32 s43, 0x00020000
  v_lshlrev_b32 v5, 10, v4
  v_bfe_u32 v6, v2, 2, 2
  v_lshl_add_u32 v5, v6, 7, v5
  v_bfe_u32 v6, v2, 4, 1
  v_lshl_add_u32 v5, v6, 5, v5
  v_and_b32 v6, 3, v2
  v_lshl_add_u32 v5, v6, 3, v5
  s_lshl_b32 s26, s6, 6
  v_add_u32 v5, s26, v5
  v_mov_b32 v80, 0
  v_mov_b32 v81, 0
  v_mov_b32 v82, 0
  v_mov_b32 v83, 0
  v_mov_b32 v84, 0
  v_mov_b32 v85, 0
  v_mov_b32 v86, 0
  v_mov_b32 v87, 0
  v_mov_b32 v88, 0
  v_mov_b32 v89, 0
  v_mov_b32 v90, 0
  v_mov_b32 v91, 0
  v_mov_b32 v92, 0
  v_mov_b32 v93, 0
  v_mov_b32 v94, 0
  v_mov_b32 v95, 0
  v_mov_b32 v96, 0
  v_mov_b32 v97, 0
  v_mov_b32 v98, 0
  v_mov_b32 v99, 0
  v_mov_b32 v100, 0
  v_mov_b32 v101, 0
  v_mov_b32 v102, 0
  v_mov_b32 v103, 0
  v_mov_b32 v104, 0
  v_mov_b32 v105, 0
  v_mov_b32 v106, 0
  v_mov_b32 v107, 0
  v_mov_b32 v108, 0
  v_mov_b32 v109, 0
  v_mov_b32 v110, 0
  v_mov_b32 v111, 0
  v_lshl_add_u32 v9, v4, 2, s4
  v_lshlrev_b32 v9, 8, v9
  v_lshl_add_u32 v9, v3, 2, v9
  s_lshl_b32 s26, s6, 7
  v_add_u32 v9, s26, v9
  s_mov_b32 s64, 0
  s_mov_b32 s65, 2048
  s_mov_b32 s66, 4096
  s_mov_b32 s67, 6144
  v_mov_b32 v12, 0x477fe000
  v_mov_b32 v11, 0xc77fe000
  s_waitcnt vmcnt(4)
  ds_write_b128 v10, v[32:35] offset:0
  ds_write_b128 v10, v[36:39] offset:8192
  s_waitcnt lgkmcnt(0)
  s_barrier
  ds_read_b64_tr_b16 v[48:49], v5 offset:0
  ds_read_b64_tr_b16 v[50:51], v5 offset:512
  ds_read_b64_tr_b16 v[52:53], v5 offset:2048
  ds_read_b64_tr_b16 v[54:55], v5 offset:2560
  ds_read_b64_tr_b16 v[56:57], v5 offset:4096
  ds_read_b64_tr_b16 v[58:59], v5 offset:4608
  ds_read_b64_tr_b16 v[60:61], v5 offset:6144
  ds_read_b64_tr_b16 v[62:63], v5 offset:6656
  ds_read_b64_tr_b16 v[64:65], v5 offset:8192
  ds_read_b64_tr_b16 v[66:67], v5 offset:8704
  ds_read_b64_tr_b16 v[68:69], v5 offset:10240
  ds_read_b64_tr_b16 v[70:71], v5 offset:10752
  ds_read_b64_tr_b16 v[72:73], v5 offset:12288
  ds_read_b64_tr_b16 v[74:75], v5 offset:12800
  ds_read_b64_tr_b16 v[76:77], v5 offset:14336
  ds_read_b64_tr_b16 v[78:79], v5 offset:14848
  s_waitcnt vmcnt(0) lgkmcnt(0)
  v_mfma_f32_32x32x16_bf16 v[80:95], v[16:19], v[48:51], v[80:95]
  v_mfma_f32_32x32x16_bf16 v[80:95], v[20:23], v[52:55], v[80:95]
  v_mfma_f32_32x32x16_bf16 v[80:95], v[24:27], v[56:59], v[80:95]
  v_mfma_f32_32x32x16_bf16 v[80:95], v[28:31], v[60:63], v[80:95]
  v_mfma_f32_32x32x16_bf16 v[96:111], v[16:19], v[64:67], v[96:111]
  v_mfma_f32_32x32x16_bf16 v[96:111], v[20:23], v[68:71], v[96:111]
  v_mfma_f32_32x32x16_bf16 v[96:111], v[24:27], v[72:75], v[96:111]
  v_mfma_f32_32x32x16_bf16 v[96:111], v[28:31], v[76:79], v[96:111]
  s_nop 15
  s_nop 3
  v_mul_f32 v13, 0xbfb8aa3b, v80
  v_med3_f32 v13, v13, v11, v12
  v_cvt_f16_f32 v13, v13
  v_and_b32 v13, 0xffff, v13
  v_and_b32 v14, 0x7fffffff, v96
  v_and_b32 v15, 0x80000000, v96
  v_sub_u32 v14, v14, v13
  v_add_u32 v14, 0x8000, v14
  v_max_i32 v14, 0, v14
  v_min_i32 v14, 0x7f7fffff, v14
  v_and_b32 v14, 0xffff0000, v14
  v_or3_b32 v80, v14, v15, v13
  buffer_store_dword v80, v9, s[40:43], s64 offen offset:0 sc1
  v_mul_f32 v13, 0xbfb8aa3b, v81
  v_med3_f32 v13, v13, v11, v12
  v_cvt_f16_f32 v13, v13
  v_and_b32 v13, 0xffff, v13
  v_and_b32 v14, 0x7fffffff, v97
  v_and_b32 v15, 0x80000000, v97
  v_sub_u32 v14, v14, v13
  v_add_u32 v14, 0x8000, v14
  v_max_i32 v14, 0, v14
  v_min_i32 v14, 0x7f7fffff, v14
  v_and_b32 v14, 0xffff0000, v14
  v_or3_b32 v81, v14, v15, v13
  buffer_store_dword v81, v9, s[40:43], s64 offen offset:256 sc1
  v_mul_f32 v13, 0xbfb8aa3b, v82
  v_med3_f32 v13, v13, v11, v12
  v_cvt_f16_f32 v13, v13
  v_and_b32 v13, 0xffff, v13
  v_and_b32 v14, 0x7fffffff, v98
  v_and_b32 v15, 0x80000000, v98
  v_sub_u32 v14, v14, v13
  v_add_u32 v14, 0x8000, v14
  v_max_i32 v14, 0, v14
  v_min_i32 v14, 0x7f7fffff, v14
  v_and_b32 v14, 0xffff0000, v14
  v_or3_b32 v82, v14, v15, v13
  buffer_store_dword v82, v9, s[40:43], s64 offen offset:512 sc1
  v_mul_f32 v13, 0xbfb8aa3b, v83
  v_med3_f32 v13, v13, v11, v12
  v_cvt_f16_f32 v13, v13
  v_and_b32 v13, 0xffff, v13
  v_and_b32 v14, 0x7fffffff, v99
  v_and_b32 v15, 0x80000000, v99
  v_sub_u32 v14, v14, v13
  v_add_u32 v14, 0x8000, v14
  v_max_i32 v14, 0, v14
  v_min_i32 v14, 0x7f7fffff, v14
  v_and_b32 v14, 0xffff0000, v14
  v_or3_b32 v83, v14, v15, v13
  buffer_store_dword v83, v9, s[40:43], s64 offen offset:768 sc1
  v_mul_f32 v13, 0xbfb8aa3b, v84
  v_med3_f32 v13, v13, v11, v12
  v_cvt_f16_f32 v13, v13
  v_and_b32 v13, 0xffff, v13
  v_and_b32 v14, 0x7fffffff, v100
  v_and_b32 v15, 0x80000000, v100
  v_sub_u32 v14, v14, v13
  v_add_u32 v14, 0x8000, v14
  v_max_i32 v14, 0, v14
  v_min_i32 v14, 0x7f7fffff, v14
  v_and_b32 v14, 0xffff0000, v14
  v_or3_b32 v84, v14, v15, v13
  buffer_store_dword v84, v9, s[40:43], s65 offen offset:0 sc1
  v_mul_f32 v13, 0xbfb8aa3b, v85
  v_med3_f32 v13, v13, v11, v12
  v_cvt_f16_f32 v13, v13
  v_and_b32 v13, 0xffff, v13
  v_and_b32 v14, 0x7fffffff, v101
  v_and_b32 v15, 0x80000000, v101
  v_sub_u32 v14, v14, v13
  v_add_u32 v14, 0x8000, v14
  v_max_i32 v14, 0, v14
  v_min_i32 v14, 0x7f7fffff, v14
  v_and_b32 v14, 0xffff0000, v14
  v_or3_b32 v85, v14, v15, v13
  buffer_store_dword v85, v9, s[40:43], s65 offen offset:256 sc1
  v_mul_f32 v13, 0xbfb8aa3b, v86
  v_med3_f32 v13, v13, v11, v12
  v_cvt_f16_f32 v13, v13
  v_and_b32 v13, 0xffff, v13
  v_and_b32 v14, 0x7fffffff, v102
  v_and_b32 v15, 0x80000000, v102
  v_sub_u32 v14, v14, v13
  v_add_u32 v14, 0x8000, v14
  v_max_i32 v14, 0, v14
  v_min_i32 v14, 0x7f7fffff, v14
  v_and_b32 v14, 0xffff0000, v14
  v_or3_b32 v86, v14, v15, v13
  buffer_store_dword v86, v9, s[40:43], s65 offen offset:512 sc1
  v_mul_f32 v13, 0xbfb8aa3b, v87
  v_med3_f32 v13, v13, v11, v12
  v_cvt_f16_f32 v13, v13
  v_and_b32 v13, 0xffff, v13
  v_and_b32 v14, 0x7fffffff, v103
  v_and_b32 v15, 0x80000000, v103
  v_sub_u32 v14, v14, v13
  v_add_u32 v14, 0x8000, v14
  v_max_i32 v14, 0, v14
  v_min_i32 v14, 0x7f7fffff, v14
  v_and_b32 v14, 0xffff0000, v14
  v_or3_b32 v87, v14, v15, v13
  buffer_store_dword v87, v9, s[40:43], s65 offen offset:768 sc1
  v_mul_f32 v13, 0xbfb8aa3b, v88
  v_med3_f32 v13, v13, v11, v12
  v_cvt_f16_f32 v13, v13
  v_and_b32 v13, 0xffff, v13
  v_and_b32 v14, 0x7fffffff, v104
  v_and_b32 v15, 0x80000000, v104
  v_sub_u32 v14, v14, v13
  v_add_u32 v14, 0x8000, v14
  v_max_i32 v14, 0, v14
  v_min_i32 v14, 0x7f7fffff, v14
  v_and_b32 v14, 0xffff0000, v14
  v_or3_b32 v88, v14, v15, v13
  buffer_store_dword v88, v9, s[40:43], s66 offen offset:0 sc1
  v_mul_f32 v13, 0xbfb8aa3b, v89
  v_med3_f32 v13, v13, v11, v12
  v_cvt_f16_f32 v13, v13
  v_and_b32 v13, 0xffff, v13
  v_and_b32 v14, 0x7fffffff, v105
  v_and_b32 v15, 0x80000000, v105
  v_sub_u32 v14, v14, v13
  v_add_u32 v14, 0x8000, v14
  v_max_i32 v14, 0, v14
  v_min_i32 v14, 0x7f7fffff, v14
  v_and_b32 v14, 0xffff0000, v14
  v_or3_b32 v89, v14, v15, v13
  buffer_store_dword v89, v9, s[40:43], s66 offen offset:256 sc1
  v_mul_f32 v13, 0xbfb8aa3b, v90
  v_med3_f32 v13, v13, v11, v12
  v_cvt_f16_f32 v13, v13
  v_and_b32 v13, 0xffff, v13
  v_and_b32 v14, 0x7fffffff, v106
  v_and_b32 v15, 0x80000000, v106
  v_sub_u32 v14, v14, v13
  v_add_u32 v14, 0x8000, v14
  v_max_i32 v14, 0, v14
  v_min_i32 v14, 0x7f7fffff, v14
  v_and_b32 v14, 0xffff0000, v14
  v_or3_b32 v90, v14, v15, v13
  buffer_store_dword v90, v9, s[40:43], s66 offen offset:512 sc1
  v_mul_f32 v13, 0xbfb8aa3b, v91
  v_med3_f32 v13, v13, v11, v12
  v_cvt_f16_f32 v13, v13
  v_and_b32 v13, 0xffff, v13
  v_and_b32 v14, 0x7fffffff, v107
  v_and_b32 v15, 0x80000000, v107
  v_sub_u32 v14, v14, v13
  v_add_u32 v14, 0x8000, v14
  v_max_i32 v14, 0, v14
  v_min_i32 v14, 0x7f7fffff, v14
  v_and_b32 v14, 0xffff0000, v14
  v_or3_b32 v91, v14, v15, v13
  buffer_store_dword v91, v9, s[40:43], s66 offen offset:768 sc1
  v_mul_f32 v13, 0xbfb8aa3b, v92
  v_med3_f32 v13, v13, v11, v12
  v_cvt_f16_f32 v13, v13
  v_and_b32 v13, 0xffff, v13
  v_and_b32 v14, 0x7fffffff, v108
  v_and_b32 v15, 0x80000000, v108
  v_sub_u32 v14, v14, v13
  v_add_u32 v14, 0x8000, v14
  v_max_i32 v14, 0, v14
  v_min_i32 v14, 0x7f7fffff, v14
  v_and_b32 v14, 0xffff0000, v14
  v_or3_b32 v92, v14, v15, v13
  buffer_store_dword v92, v9, s[40:43], s67 offen offset:0 sc1
  v_mul_f32 v13, 0xbfb8aa3b, v93
  v_med3_f32 v13, v13, v11, v12
  v_cvt_f16_f32 v13, v13
  v_and_b32 v13, 0xffff, v13
  v_and_b32 v14, 0x7fffffff, v109
  v_and_b32 v15, 0x80000000, v109
  v_sub_u32 v14, v14, v13
  v_add_u32 v14, 0x8000, v14
  v_max_i32 v14, 0, v14
  v_min_i32 v14, 0x7f7fffff, v14
  v_and_b32 v14, 0xffff0000, v14
  v_or3_b32 v93, v14, v15, v13
  buffer_store_dword v93, v9, s[40:43], s67 offen offset:256 sc1
  v_mul_f32 v13, 0xbfb8aa3b, v94
  v_med3_f32 v13, v13, v11, v12
  v_cvt_f16_f32 v13, v13
  v_and_b32 v13, 0xffff, v13
  v_and_b32 v14, 0x7fffffff, v110
  v_and_b32 v15, 0x80000000, v110
  v_sub_u32 v14, v14, v13
  v_add_u32 v14, 0x8000, v14
  v_max_i32 v14, 0, v14
  v_min_i32 v14, 0x7f7fffff, v14
  v_and_b32 v14, 0xffff0000, v14
  v_or3_b32 v94, v14, v15, v13
  buffer_store_dword v94, v9, s[40:43], s67 offen offset:512 sc1
  v_mul_f32 v13, 0xbfb8aa3b, v95
  v_med3_f32 v13, v13, v11, v12
  v_cvt_f16_f32 v13, v13
  v_and_b32 v13, 0xffff, v13
  v_and_b32 v14, 0x7fffffff, v111
  v_and_b32 v15, 0x80000000, v111
  v_sub_u32 v14, v14, v13
  v_add_u32 v14, 0x8000, v14
  v_max_i32 v14, 0, v14
  v_min_i32 v14, 0x7f7fffff, v14
  v_and_b32 v14, 0xffff0000, v14
  v_or3_b32 v95, v14, v15, v13
  buffer_store_dword v95, v9, s[40:43], s67 offen offset:768 sc1
K1_END:
  s_endpgm
.globl mpnn_k2_kernel
.p2align 8
.type mpnn_k2_kernel,@function
mpnn_k2_kernel:
  s_cmp_ge_u32 s2, 256
  s_cbranch_scc1 K2_END
  s_load_dwordx4 s[8:11], s[0:1], 48
  s_load_dwordx2 s[12:13], s[0:1], 64
  s_load_dwordx2 s[14:15], s[0:1], 32
  s_load_dwordx2 s[16:17], s[0:1], 0
  s_load_dwordx2 s[24:25], s[0:1], 72
  v_lshrrev_b32 v1, 6, v0
  v_and_b32 v2, 63, v0
  v_readfirstlane_b32 s5, v1
  v_lshlrev_b32 v3, 4, v0
  v_lshrrev_b32 v4, 3, v0
  v_and_b32 v5, 7, v0
  v_lshlrev_b32 v5, 1, v5
  v_and_b32 v6, 15, v2
  v_lshlrev_b32 v6, 4, v6
  v_lshlrev_b32 v7, 2, v4
  s_and_b32 s7, s2, 7
  s_lshl_b32 s7, s7, 5
  s_lshr_b32 s58, s2, 3
  s_or_b32 s7, s7, s58
  s_lshl_b32 s7, s7, 10
  s_mul_i32 s6, s2, 12544
  s_waitcnt lgkmcnt(0)
  s_mov_b32 s48, s8
  s_and_b32 s49, s9, 0xffff
  s_mov_b32 s50, 16512
  s_mov_b32 s51, 0x00020000
  s_mov_b32 s44, s14
  s_and_b32 s45, s15, 0xffff
  s_mov_b32 s46, 8192
  s_mov_b32 s47, 0x00020000
  s_mov_b32 s40, s16
  s_and_b32 s41, s17, 0xffff
  s_mov_b32 s42, 1600000
  s_mov_b32 s43, 0x00020000
  s_add_u32 s28, s24, 20971520
  s_addc_u32 s29, s25, 0
  s_and_b32 s29, s29, 0xffff
  s_mov_b32 s30, 263168
  s_mov_b32 s31, 0x00020000
  buffer_load_dword v8, v7, s[28:31], s7 offen
  buffer_load_dword v9, v7, s[28:31], s7 offen offset:1024
  buffer_load_dword v24, v7, s[28:31], s7 offen offset:512
  buffer_load_dword v25, v7, s[28:31], s7 offen offset:1536
  s_add_u32 s32, s24, 12582912
  s_addc_u32 s33, s25, 0
  s_and_b32 s33, s33, 0xffff
  s_mov_b32 s34, 6400000
  s_mov_b32 s35, 0x00020000
  s_add_u32 s36, s24, 0
  s_addc_u32 s37, s25, 0
  s_and_b32 s37, s37, 0xffff
  s_mov_b32 s38, 12544
  s_mov_b32 s39, 0x00020000
  s_or_b32 s37, s37, 0x01000000
  s_mov_b32 s52, s10
  s_and_b32 s53, s11, 0xffff
  s_mov_b32 s54, 1600000
  s_mov_b32 s55, 0x00020000
  v_mov_b32 v120, 0
  v_mov_b32 v121, 0
  v_mov_b32 v122, 0
  v_mov_b32 v123, 0
  s_cmp_lg_u32 s5, 0
  s_cbranch_scc1 K2_Z2
  ds_write_b128 v3, v[120:123] offset:0
K2_Z2:
  v_lshrrev_b32 v10, 4, v2
  v_and_b32 v11, 1, v10
  v_lshlrev_b32 v11, 3, v11
  v_lshrrev_b32 v10, 1, v10
  v_lshl_add_u32 v11, v10, 2, v11
  v_add_u32 v36, v11, v6
  v_mov_b32 v27, 1
  v_mov_b32 v32, 0x3c00
  s_mov_b32 s60, 0
  v_mov_b32 v11, 25600
  v_add_u32 v10, 128, v4
  s_waitcnt vmcnt(0)
  v_sub_u32 v9, v9, v8
  v_sub_u32 v25, v25, v24
  v_cmp_gt_u32 vcc, 250, v10
  v_add_u32 v8, v8, v5
  v_add_u32 v24, v24, v5
  v_cndmask_b32 v25, 0, v25, vcc
  v_min_u32 v9, 3200, v9
  v_min_u32 v25, 3200, v25
  v_lshlrev_b32 v8, 3, v8
  v_lshlrev_b32 v24, 3, v24
  v_mad_u32_u24 v8, v4, v11, v8
  v_mad_u32_u24 v24, v10, v11, v24
  v_max_u32 v23, v9, v25
  v_sub_u32 v26, v9, v5
  v_sub_u32 v25, v25, v5
K2_ROUND:
  v_cmpx_lt_i32 vcc, 0, v26
  s_cbranch_execz K2_LD_DONE0
  buffer_load_dwordx4 v[40:43], v8, s[32:35], 0 offen offset:0
  v_cmpx_lt_i32 vcc, 16, v26
  s_cbranch_execz K2_LD_DONE0
  buffer_load_dwordx4 v[44:47], v8, s[32:35], 0 offen offset:128
  v_cmpx_lt_i32 vcc, 32, v26
  s_cbranch_execz K2_LD_DONE0
  buffer_load_dwordx4 v[48:51], v8, s[32:35], 0 offen offset:256
K2_LD_DONE0:
  s_mov_b64 exec, -1
  v_cmpx_lt_i32 vcc, 0, v25
  s_cbranch_execz K2_LD_DONE1
  buffer_load_dwordx4 v[52:55], v24, s[32:35], 0 offen offset:0
  v_cmpx_lt_i32 vcc, 16, v25
  s_cbranch_execz K2_LD_DONE1
  buffer_load_dwordx4 v[56:59], v24, s[32:35], 0 offen offset:128
  v_cmpx_lt_i32 vcc, 32, v25
  s_cbranch_execz K2_LD_DONE1
  buffer_load_dwordx4 v[60:63], v24, s[32:35], 0 offen offset:256
K2_LD_DONE1:
  s_mov_b64 exec, -1
  s_cmp_lg_u32 s60, 0
  s_cbranch_scc1 K2_SETUP_SKIP
  v_lshrrev_b32 v10, 1, v6
  v_add_u32 v10, 16384, v10
  buffer_load_dwordx2 v[20:21], v10, s[48:51], 0 offen
  v_and_b32 v10, 0x1ff0, v3
  s_cmp_ge_u32 s5, 8
  s_cbranch_scc1 K2_W1
  buffer_load_dwordx4 v[12:15], v10, s[48:51], 0 offen
  s_mul_i32 s59, s2, 6272
  buffer_load_dwordx4 v[88:91], v3, s[40:43], s59 offen
  s_waitcnt lgkmcnt(0)
  s_barrier
  s_waitcnt vmcnt(3)
  s_branch K2_W2
K2_W1:
  buffer_load_dwordx4 v[12:15], v10, s[44:47], 0 offen
  s_waitcnt lgkmcnt(0)
  s_barrier
  s_waitcnt vmcnt(2)
K2_W2:
  v_mov_b32 v11, 512
  ds_max_u32 v11, v23
  s_branch K2_SETUP_DONE
K2_SETUP_SKIP:
  s_waitcnt lgkmcnt(0)
  s_barrier
  s_waitcnt vmcnt(0)
K2_SETUP_DONE:
  v_cmpx_lt_i32 vcc, 0, v26
  s_cbranch_execz K2_AT_DONE0
  v_lshlrev_b32 v41, 2, v41
  ds_add_rtn_u32 v64, v41, v27 offset:0
  v_cmpx_lt_i32 vcc, 1, v26
  s_cbranch_execz K2_AT_DONE0
  v_lshlrev_b32 v43, 2, v43
  ds_add_rtn_u32 v65, v43, v27 offset:0
  v_cmpx_lt_i32 vcc, 16, v26
  s_cbranch_execz K2_AT_DONE0
  v_lshlrev_b32 v45, 2, v45
  ds_add_rtn_u32 v66, v45, v27 offset:0
  v_cmpx_lt_i32 vcc, 17, v26
  s_cbranch_execz K2_AT_DONE0
  v_lshlrev_b32 v47, 2, v47
  ds_add_rtn_u32 v67, v47, v27 offset:0
  v_cmpx_lt_i32 vcc, 32, v26
  s_cbranch_execz K2_AT_DONE0
  v_lshlrev_b32 v49, 2, v49
  ds_add_rtn_u32 v68, v49, v27 offset:0
  v_cmpx_lt_i32 vcc, 33, v26
  s_cbranch_execz K2_AT_DONE0
  v_lshlrev_b32 v51, 2, v51
  ds_add_rtn_u32 v69, v51, v27 offset:0
K2_AT_DONE0:
  s_mov_b64 exec, -1
  v_cmpx_lt_i32 vcc, 0, v25
  s_cbranch_execz K2_AT_DONE1
  v_lshlrev_b32 v53, 2, v53
  ds_add_rtn_u32 v70, v53, v27 offset:0
  v_cmpx_lt_i32 vcc, 1, v25
  s_cbranch_execz K2_AT_DONE1
  v_lshlrev_b32 v55, 2, v55
  ds_add_rtn_u32 v71, v55, v27 offset:0
  v_cmpx_lt_i32 vcc, 16, v25
  s_cbranch_execz K2_AT_DONE1
  v_lshlrev_b32 v57, 2, v57
  ds_add_rtn_u32 v72, v57, v27 offset:0
  v_cmpx_lt_i32 vcc, 17, v25
  s_cbranch_execz K2_AT_DONE1
  v_lshlrev_b32 v59, 2, v59
  ds_add_rtn_u32 v73, v59, v27 offset:0
  v_cmpx_lt_i32 vcc, 32, v25
  s_cbranch_execz K2_AT_DONE1
  v_lshlrev_b32 v61, 2, v61
  ds_add_rtn_u32 v74, v61, v27 offset:0
  v_cmpx_lt_i32 vcc, 33, v25
  s_cbranch_execz K2_AT_DONE1
  v_lshlrev_b32 v63, 2, v63
  ds_add_rtn_u32 v75, v63, v27 offset:0
K2_AT_DONE1:
  s_mov_b64 exec, -1
  s_waitcnt lgkmcnt(0)
  s_barrier
  s_cmp_lg_u32 s60, 0
  s_cbranch_scc1 K2_PF_SKIP
  s_lshr_b32 s58, s2, 3
  s_mul_i32 s58, s58, 100352
K2_PF_SKIP:
  v_lshlrev_b32 v11, 2, v2
  ds_read_b32 v37, v11 offset:0
  v_cmp_gt_u32 s[56:57], 49, v2
  s_waitcnt lgkmcnt(0)
  v_add_u32 v34, 3, v37
  v_and_b32 v34, -4, v34
  v_max_u32 v34, 4, v34
  v_cndmask_b32 v34, 0, v34, s[56:57]
  v_mov_b32 v35, v34
  s_nop 1
  v_add_u32_dpp v35, v35, v35 row_shr:1 row_mask:0xf bank_mask:0xf
  s_nop 1
  v_add_u32_dpp v35, v35, v35 row_shr:2 row_mask:0xf bank_mask:0xf
  s_nop 1
  v_add_u32_dpp v35, v35, v35 row_shr:4 row_mask:0xf bank_mask:0xf
  s_nop 1
  v_add_u32_dpp v35, v35, v35 row_shr:8 row_mask:0xf bank_mask:0xf
  s_nop 1
  v_add_u32_dpp v35, v35, v35 row_bcast:15 row_mask:0xa bank_mask:0xf
  s_nop 1
  v_add_u32_dpp v35, v35, v35 row_bcast:31 row_mask:0xc bank_mask:0xf
  s_nop 1
  v_readlane_b32 s61, v35, 63
  v_sub_u32 v35, v35, v34
  s_add_u32 s62, s61, 15
  s_and_b32 s62, s62, -16
  v_mov_b32 v33, s62
  s_nop 1
  v_cndmask_b32 v33, v33, v35, s[56:57]
  s_cmp_lg_u32 s5, 0
  s_cbranch_scc1 K2_PAD_DONE
  v_mov_b32 v38, 12500
  v_mov_b32 v39, 0
  v_add_u32 v10, v35, v37
  v_lshlrev_b32 v10, 3, v10
  v_sub_u32 v34, v34, v37
  v_cmpx_lt_u32 vcc, 0, v34
  ds_write_b64 v10, v[38:39] offset:50432
  v_cmpx_lt_u32 vcc, 1, v34
  ds_write_b64 v10, v[38:39] offset:50440
  v_cmpx_lt_u32 vcc, 2, v34
  ds_write_b64 v10, v[38:39] offset:50448
  v_cmpx_lt_u32 vcc, 3, v34
  ds_write_b64 v10, v[38:39] offset:50456
  s_mov_b64 exec, -1
  v_add_u32 v10, s61, v2
  v_lshlrev_b32 v10, 3, v10
  v_cmpx_gt_u32 vcc, 16, v2
  ds_write_b64 v10, v[38:39] offset:50432
  s_mov_b64 exec, -1
K2_PAD_DONE:
  v_cmp_lt_i32 vcc, 0, v26
  s_cbranch_vccz K2_SC1_DONE0
  ds_bpermute_b32 v76, v41, v33
  v_cmp_lt_i32 vcc, 1, v26
  s_cbranch_vccz K2_SC1_DONE0
  ds_bpermute_b32 v77, v43, v33
  v_cmp_lt_i32 vcc, 16, v26
  s_cbranch_vccz K2_SC1_DONE0
  ds_bpermute_b32 v78, v45, v33
  v_cmp_lt_i32 vcc, 17, v26
  s_cbranch_vccz K2_SC1_DONE0
  ds_bpermute_b32 v79, v47, v33
  v_cmp_lt_i32 vcc, 32, v26
  s_cbranch_vccz K2_SC1_DONE0
  ds_bpermute_b32 v80, v49, v33
  v_cmp_lt_i32 vcc, 33, v26
  s_cbranch_vccz K2_SC1_DONE0
  ds_bpermute_b32 v81, v51, v33
K2_SC1_DONE0:
  v_cmp_lt_i32 vcc, 0, v25
  s_cbranch_vccz K2_SC1_DONE1
  ds_bpermute_b32 v82, v53, v33
  v_cmp_lt_i32 vcc, 1, v25
  s_cbranch_vccz K2_SC1_DONE1
  ds_bpermute_b32 v83, v55, v33
  v_cmp_lt_i32 vcc, 16, v25
  s_cbranch_vccz K2_SC1_DONE1
  ds_bpermute_b32 v84, v57, v33
  v_cmp_lt_i32 vcc, 17, v25
  s_cbranch_vccz K2_SC1_DONE1
  ds_bpermute_b32 v85, v59, v33
  v_cmp_lt_i32 vcc, 32, v25
  s_cbranch_vccz K2_SC1_DONE1
  ds_bpermute_b32 v86, v61, v33
  v_cmp_lt_i32 vcc, 33, v25
  s_cbranch_vccz K2_SC1_DONE1
  ds_bpermute_b32 v87, v63, v33
K2_SC1_DONE1:
  s_waitcnt lgkmcnt(0)
  v_cmpx_lt_i32 vcc, 0, v26
  s_cbranch_execz K2_SC2_DONE0
  v_add_u32 v11, v76, v64
  v_lshlrev_b32 v11, 3, v11
  v_and_b32 v41, 0xffff0000, v40
  v_and_b32 v40, 0x3fff, v40
  ds_write_b64 v11, v[40:41] offset:50432
  v_cmpx_lt_i32 vcc, 1, v26
  s_cbranch_execz K2_SC2_DONE0
  v_add_u32 v11, v77, v65
  v_lshlrev_b32 v11, 3, v11
  v_and_b32 v43, 0xffff0000, v42
  v_and_b32 v42, 0x3fff, v42
  ds_write_b64 v11, v[42:43] offset:50432
  v_cmpx_lt_i32 vcc, 16, v26
  s_cbranch_execz K2_SC2_DONE0
  v_add_u32 v11, v78, v66
  v_lshlrev_b32 v11, 3, v11
  v_and_b32 v45, 0xffff0000, v44
  v_and_b32 v44, 0x3fff, v44
  ds_write_b64 v11, v[44:45] offset:50432
  v_cmpx_lt_i32 vcc, 17, v26
  s_cbranch_execz K2_SC2_DONE0
  v_add_u32 v11, v79, v67
  v_lshlrev_b32 v11, 3, v11
  v_and_b32 v47, 0xffff0000, v46
  v_and_b32 v46, 0x3fff, v46
  ds_write_b64 v11, v[46:47] offset:50432
  v_cmpx_lt_i32 vcc, 32, v26
  s_cbranch_execz K2_SC2_DONE0
  v_add_u32 v11, v80, v68
  v_lshlrev_b32 v11, 3, v11
  v_and_b32 v49, 0xffff0000, v48
  v_and_b32 v48, 0x3fff, v48
  ds_write_b64 v11, v[48:49] offset:50432
  v_cmpx_lt_i32 vcc, 33, v26
  s_cbranch_execz K2_SC2_DONE0
  v_add_u32 v11, v81, v69
  v_lshlrev_b32 v11, 3, v11
  v_and_b32 v51, 0xffff0000, v50
  v_and_b32 v50, 0x3fff, v50
  ds_write_b64 v11, v[50:51] offset:50432
K2_SC2_DONE0:
  s_mov_b64 exec, -1
  v_cmpx_lt_i32 vcc, 0, v25
  s_cbranch_execz K2_SC2_DONE1
  v_add_u32 v11, v82, v70
  v_lshlrev_b32 v11, 3, v11
  v_and_b32 v53, 0xffff0000, v52
  v_and_b32 v52, 0x3fff, v52
  ds_write_b64 v11, v[52:53] offset:50432
  v_cmpx_lt_i32 vcc, 1, v25
  s_cbranch_execz K2_SC2_DONE1
  v_add_u32 v11, v83, v71
  v_lshlrev_b32 v11, 3, v11
  v_and_b32 v55, 0xffff0000, v54
  v_and_b32 v54, 0x3fff, v54
  ds_write_b64 v11, v[54:55] offset:50432
  v_cmpx_lt_i32 vcc, 16, v25
  s_cbranch_execz K2_SC2_DONE1
  v_add_u32 v11, v84, v72
  v_lshlrev_b32 v11, 3, v11
  v_and_b32 v57, 0xffff0000, v56
  v_and_b32 v56, 0x3fff, v56
  ds_write_b64 v11, v[56:57] offset:50432
  v_cmpx_lt_i32 vcc, 17, v25
  s_cbranch_execz K2_SC2_DONE1
  v_add_u32 v11, v85, v73
  v_lshlrev_b32 v11, 3, v11
  v_and_b32 v59, 0xffff0000, v58
  v_and_b32 v58, 0x3fff, v58
  ds_write_b64 v11, v[58:59] offset:50432
  v_cmpx_lt_i32 vcc, 32, v25
  s_cbranch_execz K2_SC2_DONE1
  v_add_u32 v11, v86, v74
  v_lshlrev_b32 v11, 3, v11
  v_and_b32 v61, 0xffff0000, v60
  v_and_b32 v60, 0x3fff, v60
  ds_write_b64 v11, v[60:61] offset:50432
  v_cmpx_lt_i32 vcc, 33, v25
  s_cbranch_execz K2_SC2_DONE1
  v_add_u32 v11, v87, v75
  v_lshlrev_b32 v11, 3, v11
  v_and_b32 v63, 0xffff0000, v62
  v_and_b32 v62, 0x3fff, v62
  ds_write_b64 v11, v[62:63] offset:50432
K2_SC2_DONE1:
  s_mov_b64 exec, -1
  s_cmp_lg_u32 s60, 0
  s_cbranch_scc1 K2_WST_SKIP
  s_waitcnt vmcnt(0)
  ds_write_b128 v3, v[12:15] offset:1024
  s_cmp_ge_u32 s5, 8
  s_cbranch_scc1 K2_XST
  v_lshrrev_b32 v10, 3, v0
  v_lshl_add_u32 v10, v10, 4, v3
  v_add_u32 v10, 153600, v10
  ds_write_b128 v10, v[88:91]
K2_XST:
  v_lshlrev_b32 v28, 16, v20
  v_and_b32 v29, 0xffff0000, v20
  v_lshlrev_b32 v30, 16, v21
  v_and_b32 v31, 0xffff0000, v21
  v_mul_f32 v28, 0xbfb8aa3b, v28
  v_mul_f32 v29, 0xbfb8aa3b, v29
  v_mul_f32 v30, 0xbfb8aa3b, v30
  v_mul_f32 v31, 0xbfb8aa3b, v31
K2_WST_SKIP:
  v_readlane_b32 s62, v33, 49
  s_lshr_b32 s63, s62, 2
  s_mul_i32 s64, s63, s5
  s_lshr_b32 s64, s64, 4
  s_add_u32 s65, s5, 1
  s_mul_i32 s65, s63, s65
  s_lshr_b32 s65, s65, 4
  s_lshl_b32 s66, s64, 2
  s_lshl_b32 s67, s65, 2
  v_cmp_gt_u32 s[56:57], 49, v2
  v_cmp_ge_u32 vcc, s66, v33
  s_and_b64 vcc, vcc, s[56:57]
  s_bcnt1_i32_b64 s68, vcc
  s_sub_u32 s68, s68, 1
  s_add_u32 s69, s68, 1
  v_readlane_b32 s70, v33, s69
  v_readlane_b32 s72, v33, s68
  s_cmp_lg_u32 s72, s66
  s_cselect_b32 s73, 1, 0
  s_cmp_ge_u32 s64, s65
  s_cselect_b32 s73, 0, s73
  s_cmp_lg_u32 s73, 0
  s_cselect_b32 s74, s68, -1
  v_mov_b32 v11, s74
  s_lshl_b32 s74, s5, 2
  v_mov_b32 v10, s74
  ds_write_b32 v10, v11 offset:576
  s_waitcnt lgkmcnt(0)
  s_barrier
  v_lshrrev_b32 v11, 4, v2
  v_lshlrev_b32 v11, 3, v11
  s_lshl_b32 s71, s66, 3
  v_add_u32 v34, s71, v11
  v_mov_b32 v38, 1.0
  v_mov_b32 v39, 1.0
  v_mov_b32 v49, v6
  v_mov_b32 v51, v6
  v_mov_b32 v53, v6
  v_mov_b32 v55, v6
  ds_read_b32 v48, v34 offset:50432
  ds_read_b32 v12, v34 offset:50436
  ds_read_b32 v50, v34 offset:50464
  ds_read_b32 v13, v34 offset:50468
  ds_read_b32 v52, v34 offset:50496
  ds_read_b32 v14, v34 offset:50500
  ds_read_b32 v54, v34 offset:50528
  ds_read_b32 v15, v34 offset:50532
  v_add_u32 v34, 128, v34
  v_mov_b32 v37, v34
  s_waitcnt lgkmcnt(0)
  s_add_u32 s78, s66, 0
  s_cmp_lt_u32 s78, s67
  s_cselect_b32 s38, 12544, 0
  buffer_load_dwordx4 v[72:75], v[48:49], s[36:39], 0 idxen offen
  ds_read_b32 v48, v37 offset:50432
  s_add_u32 s78, s66, 4
  s_cmp_lt_u32 s78, s67
  s_cselect_b32 s38, 12544, 0
  buffer_load_dwordx4 v[76:79], v[50:51], s[36:39], 0 idxen offen
  ds_read_b32 v50, v37 offset:50464
  s_add_u32 s78, s66, 8
  s_cmp_lt_u32 s78, s67
  s_cselect_b32 s38, 12544, 0
  buffer_load_dwordx4 v[80:83], v[52:53], s[36:39], 0 idxen offen
  ds_read_b32 v52, v37 offset:50496
  v_add_u32 v37, 96, v37
  s_cmp_lg_u32 s60, 0
  s_cbranch_scc1 K2_MM_SKIP
  s_cmp_ge_u32 s5, 8
  s_cbranch_scc1 K2_MM_DONE
  v_lshrrev_b32 v1, 5, v2
  v_lshlrev_b32 v7, 10, v1
  v_bfe_u32 v11, v2, 2, 2
  v_lshl_add_u32 v7, v11, 7, v7
  v_bfe_u32 v11, v2, 4, 1
  v_lshl_add_u32 v7, v11, 5, v7
  v_and_b32 v11, 3, v2
  v_lshl_add_u32 v7, v11, 3, v7
  s_and_b32 s58, s5, 1
  s_bfe_u32 s59, s5, 0x10001
  s_lshl_b32 s78, s58, 6
  s_lshl_b32 s79, s59, 13
  s_add_u32 s78, s78, s79
  v_add_u32 v7, s78, v7
  s_lshr_b32 s78, s5, 2
  s_mul_i32 s78, s78, 4608
  s_add_u32 s78, s78, 153600
  v_and_b32 v11, 31, v2
  v_mul_u32_u24 v11, 144, v11
  v_lshl_add_u32 v11, v1, 4, v11
  v_add_u32 v11, s78, v11
  v_mov_b32 v104, 0
  v_mov_b32 v105, 0
  v_mov_b32 v106, 0
  v_mov_b32 v107, 0
  v_mov_b32 v108, 0
  v_mov_b32 v109, 0
  v_mov_b32 v110, 0
  v_mov_b32 v111, 0
  v_mov_b32 v112, 0
  v_mov_b32 v113, 0
  v_mov_b32 v114, 0
  v_mov_b32 v115, 0
  v_mov_b32 v116, 0
  v_mov_b32 v117, 0
  v_mov_b32 v118, 0
  v_mov_b32 v119, 0
  ds_read_b64_tr_b16 v[40:41], v7 offset:1024
  ds_read_b64_tr_b16 v[42:43], v7 offset:1536
  ds_read_b128 v[120:123], v11 offset:0
  ds_read_b64_tr_b16 v[44:45], v7 offset:3072
  ds_read_b64_tr_b16 v[46:47], v7 offset:3584
  ds_read_b128 v[124:127], v11 offset:32
  s_waitcnt lgkmcnt(0)
  v_mfma_f32_32x32x16_bf16 v[104:119], v[120:123], v[40:43], v[104:119]
  v_mfma_f32_32x32x16_bf16 v[104:119], v[124:127], v[44:47], v[104:119]
  s_nop 7
  ds_read_b64_tr_b16 v[40:41], v7 offset:5120
  ds_read_b64_tr_b16 v[42:43], v7 offset:5632
  ds_read_b128 v[120:123], v11 offset:64
  ds_read_b64_tr_b16 v[44:45], v7 offset:7168
  ds_read_b64_tr_b16 v[46:47], v7 offset:7680
  ds_read_b128 v[124:127], v11 offset:96
  s_waitcnt lgkmcnt(0)
  v_mfma_f32_32x32x16_bf16 v[104:119], v[120:123], v[40:43], v[104:119]
  v_mfma_f32_32x32x16_bf16 v[104:119], v[124:127], v[44:47], v[104:119]
  s_nop 7
  s_lshr_b32 s78, s5, 2
  s_lshl_b32 s78, s78, 13
  s_lshl_b32 s79, s58, 7
  s_add_u32 s78, s78, s79
  s_lshl_b32 s79, s59, 14
  s_add_u32 s78, s78, s79
  v_lshlrev_b32 v7, 10, v1
  v_and_b32 v11, 31, v2
  v_lshl_add_u32 v7, v11, 2, v7
  v_add_u32 v7, s78, v7
  s_cmp_eq_u32 s59, 0
  s_cselect_b32 s79, 0xbfb8aa3b, 1.0
  v_mov_b32 v11, s79
  s_nop 7
  v_mul_f32 v104, v104, v11
  ds_write_b32 v7, v104 offset:17664
  v_mul_f32 v105, v105, v11
  ds_write_b32 v7, v105 offset:17920
  v_mul_f32 v106, v106, v11
  ds_write_b32 v7, v106 offset:18176
  v_mul_f32 v107, v107, v11
  ds_write_b32 v7, v107 offset:18432
  v_mul_f32 v108, v108, v11
  ds_write_b32 v7, v108 offset:19712
  v_mul_f32 v109, v109, v11
  ds_write_b32 v7, v109 offset:19968
  v_mul_f32 v110, v110, v11
  ds_write_b32 v7, v110 offset:20224
  v_mul_f32 v111, v111, v11
  ds_write_b32 v7, v111 offset:20480
  v_mul_f32 v112, v112, v11
  ds_write_b32 v7, v112 offset:21760
  v_mul_f32 v113, v113, v11
  ds_write_b32 v7, v113 offset:22016
  v_mul_f32 v114, v114, v11
  ds_write_b32 v7, v114 offset:22272
  v_mul_f32 v115, v115, v11
  ds_write_b32 v7, v115 offset:22528
  v_mul_f32 v116, v116, v11
  ds_write_b32 v7, v116 offset:23808
  v_mul_f32 v117, v117, v11
  ds_write_b32 v7, v117 offset:24064
  v_mul_f32 v118, v118, v11
  ds_write_b32 v7, v118 offset:24320
  v_mul_f32 v119, v119, v11
  ds_write_b32 v7, v119 offset:24576
  s_cmp_lg_u32 s59, 0
  s_cbranch_scc1 K2_MM_DONE
  v_and_b32 v11, 0x7fffffff, v104
  v_and_b32 v1, 0x7fffffff, v105
  v_max_u32 v11, v11, v1
  v_and_b32 v1, 0x7fffffff, v106
  v_max_u32 v11, v11, v1
  v_and_b32 v1, 0x7fffffff, v107
  v_max_u32 v11, v11, v1
  v_and_b32 v1, 0x7fffffff, v108
  v_max_u32 v11, v11, v1
  v_and_b32 v1, 0x7fffffff, v109
  v_max_u32 v11, v11, v1
  v_and_b32 v1, 0x7fffffff, v110
  v_max_u32 v11, v11, v1
  v_and_b32 v1, 0x7fffffff, v111
  v_max_u32 v11, v11, v1
  v_and_b32 v1, 0x7fffffff, v112
  v_max_u32 v11, v11, v1
  v_and_b32 v1, 0x7fffffff, v113
  v_max_u32 v11, v11, v1
  v_and_b32 v1, 0x7fffffff, v114
  v_max_u32 v11, v11, v1
  v_and_b32 v1, 0x7fffffff, v115
  v_max_u32 v11, v11, v1
  v_and_b32 v1, 0x7fffffff, v116
  v_max_u32 v11, v11, v1
  v_and_b32 v1, 0x7fffffff, v117
  v_max_u32 v11, v11, v1
  v_and_b32 v1, 0x7fffffff, v118
  v_max_u32 v11, v11, v1
  v_and_b32 v1, 0x7fffffff, v119
  v_max_u32 v11, v11, v1
  v_mov_b32 v1, 516
  ds_max_u32 v1, v11
K2_MM_DONE:
  s_waitcnt lgkmcnt(0)
  s_barrier
  v_mov_b32 v1, 516
  ds_read_b32 v11, v1
  s_waitcnt lgkmcnt(0)
  v_readfirstlane_b32 s75, v11
  s_cmp_le_u32 s75, 0x42700000
  s_cselect_b32 s75, 1, 0
K2_MM_SKIP:
  s_cmp_ge_u32 s64, s65
  s_cbranch_scc1 K2_NOFINAL
  s_lshl_b32 s71, s68, 8
  v_add_u32 v35, s71, v6
  ds_read_b128 v[40:43], v35 offset:17664
  v_mov_b32 v44, 0
  v_mov_b32 v45, 0
  v_mov_b32 v46, 0
  v_mov_b32 v47, 0
  s_setprio 3
  s_waitcnt lgkmcnt(0)
  s_cmp_eq_u32 s75, 0
  s_cbranch_scc1 K2_LOOP
  v_exp_f32 v40, v40
  v_exp_f32 v41, v41
  v_exp_f32 v42, v42
  v_exp_f32 v43, v43
K2_LOOPF:
  s_waitcnt lgkmcnt(2)
  s_add_u32 s78, s66, 12
  s_cmp_lt_u32 s78, s67
  s_cselect_b32 s38, 12544, 0
  buffer_load_dwordx4 v[84:87], v[54:55], s[36:39], 0 idxen offen
  ds_read_b32 v54, v37 offset:50432
  s_waitcnt vmcnt(3)
  v_fma_mix_f32 v120, v12, v28, v72 op_sel_hi:[0,0,1]
  v_fma_mix_f32 v121, v12, v29, v73 op_sel_hi:[0,0,1]
  v_fma_mix_f32 v122, v12, v30, v74 op_sel_hi:[0,0,1]
  v_fma_mix_f32 v123, v12, v31, v75 op_sel_hi:[0,0,1]
  ds_read_b32 v12, v34 offset:50436
  v_exp_f32 v120, v120
  v_exp_f32 v121, v121
  v_exp_f32 v122, v122
  v_exp_f32 v123, v123
  s_add_u32 s66, s66, 4
  v_pk_fma_f32 v[120:121], v[120:121], v[40:41], v[38:39]
  v_pk_fma_f32 v[122:123], v[122:123], v[42:43], v[38:39]
  v_rcp_f32 v120, v120
  v_rcp_f32 v121, v121
  v_rcp_f32 v122, v122
  v_rcp_f32 v123, v123
  s_cmp_lg_u32 s66, s70
  v_pk_fma_f32 v[44:45], v[120:121], v[72:73], v[44:45]
  v_pk_fma_f32 v[46:47], v[122:123], v[74:75], v[46:47]
  s_cbranch_scc1 K2_NF1
  s_getpc_b64 s[76:77]
  s_add_u32 s76, s76, 12
  s_addc_u32 s77, s77, 0
  s_branch K2_FLUSH
K2_NF1:
  s_cmp_ge_u32 s66, s67
  s_cbranch_scc1 K2_LOOP_EXIT
  s_waitcnt lgkmcnt(2)
  s_add_u32 s78, s66, 12
  s_cmp_lt_u32 s78, s67
  s_cselect_b32 s38, 12544, 0
  buffer_load_dwordx4 v[72:75], v[48:49], s[36:39], 0 idxen offen
  ds_read_b32 v48, v37 offset:50464
  s_waitcnt vmcnt(3)
  v_fma_mix_f32 v124, v13, v28, v76 op_sel_hi:[0,0,1]
  v_fma_mix_f32 v125, v13, v29, v77 op_sel_hi:[0,0,1]
  v_fma_mix_f32 v126, v13, v30, v78 op_sel_hi:[0,0,1]
  v_fma_mix_f32 v127, v13, v31, v79 op_sel_hi:[0,0,1]
  ds_read_b32 v13, v34 offset:50468
  v_exp_f32 v124, v124
  v_exp_f32 v125, v125
  v_exp_f32 v126, v126
  v_exp_f32 v127, v127
  s_add_u32 s66, s66, 4
  v_pk_fma_f32 v[124:125], v[124:125], v[40:41], v[38:39]
  v_pk_fma_f32 v[126:127], v[126:127], v[42:43], v[38:39]
  v_rcp_f32 v124, v124
  v_rcp_f32 v125, v125
  v_rcp_f32 v126, v126
  v_rcp_f32 v127, v127
  s_cmp_lg_u32 s66, s70
  v_pk_fma_f32 v[44:45], v[124:125], v[76:77], v[44:45]
  v_pk_fma_f32 v[46:47], v[126:127], v[78:79], v[46:47]
  s_cbranch_scc1 K2_NF2
  s_getpc_b64 s[76:77]
  s_add_u32 s76, s76, 12
  s_addc_u32 s77, s77, 0
  s_branch K2_FLUSH
K2_NF2:
  s_cmp_ge_u32 s66, s67
  s_cbranch_scc1 K2_LOOP_EXIT
  s_waitcnt lgkmcnt(2)
  s_add_u32 s78, s66, 12
  s_cmp_lt_u32 s78, s67
  s_cselect_b32 s38, 12544, 0
  buffer_load_dwordx4 v[76:79], v[50:51], s[36:39], 0 idxen offen
  ds_read_b32 v50, v37 offset:50496
  s_waitcnt vmcnt(3)
  v_fma_mix_f32 v120, v14, v28, v80 op_sel_hi:[0,0,1]
  v_fma_mix_f32 v121, v14, v29, v81 op_sel_hi:[0,0,1]
  v_fma_mix_f32 v122, v14, v30, v82 op_sel_hi:[0,0,1]
  v_fma_mix_f32 v123, v14, v31, v83 op_sel_hi:[0,0,1]
  ds_read_b32 v14, v34 offset:50500
  v_exp_f32 v120, v120
  v_exp_f32 v121, v121
  v_exp_f32 v122, v122
  v_exp_f32 v123, v123
  s_add_u32 s66, s66, 4
  v_pk_fma_f32 v[120:121], v[120:121], v[40:41], v[38:39]
  v_pk_fma_f32 v[122:123], v[122:123], v[42:43], v[38:39]
  v_rcp_f32 v120, v120
  v_rcp_f32 v121, v121
  v_rcp_f32 v122, v122
  v_rcp_f32 v123, v123
  s_cmp_lg_u32 s66, s70
  v_pk_fma_f32 v[44:45], v[120:121], v[80:81], v[44:45]
  v_pk_fma_f32 v[46:47], v[122:123], v[82:83], v[46:47]
  s_cbranch_scc1 K2_NF3
  s_getpc_b64 s[76:77]
  s_add_u32 s76, s76, 12
  s_addc_u32 s77, s77, 0
  s_branch K2_FLUSH
K2_NF3:
  s_cmp_ge_u32 s66, s67
  s_cbranch_scc1 K2_LOOP_EXIT
  s_waitcnt lgkmcnt(2)
  s_add_u32 s78, s66, 12
  s_cmp_lt_u32 s78, s67
  s_cselect_b32 s38, 12544, 0
  buffer_load_dwordx4 v[80:83], v[52:53], s[36:39], 0 idxen offen
  ds_read_b32 v52, v37 offset:50528
  s_waitcnt vmcnt(3)
  v_fma_mix_f32 v124, v15, v28, v84 op_sel_hi:[0,0,1]
  v_fma_mix_f32 v125, v15, v29, v85 op_sel_hi:[0,0,1]
  v_fma_mix_f32 v126, v15, v30, v86 op_sel_hi:[0,0,1]
  v_fma_mix_f32 v127, v15, v31, v87 op_sel_hi:[0,0,1]
  ds_read_b32 v15, v34 offset:50532
  v_exp_f32 v124, v124
  v_exp_f32 v125, v125
  v_exp_f32 v126, v126
  v_exp_f32 v127, v127
  s_add_u32 s66, s66, 4
  v_pk_fma_f32 v[124:125], v[124:125], v[40:41], v[38:39]
  v_pk_fma_f32 v[126:127], v[126:127], v[42:43], v[38:39]
  v_rcp_f32 v124, v124
  v_rcp_f32 v125, v125
  v_rcp_f32 v126, v126
  v_rcp_f32 v127, v127
  s_cmp_lg_u32 s66, s70
  v_pk_fma_f32 v[44:45], v[124:125], v[84:85], v[44:45]
  v_pk_fma_f32 v[46:47], v[126:127], v[86:87], v[46:47]
  s_cbranch_scc1 K2_NF4
  s_getpc_b64 s[76:77]
  s_add_u32 s76, s76, 12
  s_addc_u32 s77, s77, 0
  s_branch K2_FLUSH
K2_NF4:
  s_cmp_ge_u32 s66, s67
  s_cbranch_scc1 K2_LOOP_EXIT
  v_add_u32 v34, 128, v34
  v_add_u32 v37, 128, v37
  s_sub_u32 s78, s67, s66
  s_cmp_gt_u32 s78, 96
  s_cbranch_scc1 K2_PD1
  s_cmp_gt_u32 s78, 48
  s_cbranch_scc1 K2_PA1
  s_cmp_gt_u32 s78, 16
  s_cbranch_scc1 K2_PB1
  s_setprio 0
  s_branch K2_PD1
K2_PA1:
  s_setprio 2
  s_branch K2_PD1
K2_PB1:
  s_setprio 1
K2_PD1:
  s_branch K2_LOOPF
K2_LOOP:
  s_waitcnt lgkmcnt(2)
  s_add_u32 s78, s66, 12
  s_cmp_lt_u32 s78, s67
  s_cselect_b32 s38, 12544, 0
  buffer_load_dwordx4 v[84:87], v[54:55], s[36:39], 0 idxen offen
  ds_read_b32 v54, v37 offset:50432
  s_waitcnt vmcnt(3)
  v_pk_fma_f32 v[120:121], v[12:13], v[28:29], v[40:41] op_sel:[0,0,0] op_sel_hi:[0,1,1]
  v_pk_fma_f32 v[122:123], v[12:13], v[30:31], v[42:43] op_sel:[0,0,0] op_sel_hi:[0,1,1]
  ds_read_b32 v12, v34 offset:50436
  v_dot2_f32_f16 v120, v72, v32, v120
  v_dot2_f32_f16 v121, v73, v32, v121
  v_dot2_f32_f16 v122, v74, v32, v122
  v_dot2_f32_f16 v123, v75, v32, v123
  v_exp_f32 v120, v120
  v_exp_f32 v121, v121
  v_exp_f32 v122, v122
  v_exp_f32 v123, v123
  s_add_u32 s66, s66, 4
  v_pk_add_f32 v[120:121], v[120:121], v[38:39]
  v_pk_add_f32 v[122:123], v[122:123], v[38:39]
  v_rcp_f32 v120, v120
  v_rcp_f32 v121, v121
  v_rcp_f32 v122, v122
  v_rcp_f32 v123, v123
  s_cmp_lg_u32 s66, s70
  v_pk_fma_f32 v[44:45], v[120:121], v[72:73], v[44:45]
  v_pk_fma_f32 v[46:47], v[122:123], v[74:75], v[46:47]
  s_cbranch_scc1 K2_NF5
  s_getpc_b64 s[76:77]
  s_add_u32 s76, s76, 12
  s_addc_u32 s77, s77, 0
  s_branch K2_FLUSH
K2_NF5:
  s_cmp_ge_u32 s66, s67
  s_cbranch_scc1 K2_LOOP_EXIT
  s_waitcnt lgkmcnt(2)
  s_add_u32 s78, s66, 12
  s_cmp_lt_u32 s78, s67
  s_cselect_b32 s38, 12544, 0
  buffer_load_dwordx4 v[72:75], v[48:49], s[36:39], 0 idxen offen
  ds_read_b32 v48, v37 offset:50464
  s_waitcnt vmcnt(3)
  v_pk_fma_f32 v[124:125], v[12:13], v[28:29], v[40:41] op_sel:[1,0,0] op_sel_hi:[1,1,1]
  v_pk_fma_f32 v[126:127], v[12:13], v[30:31], v[42:43] op_sel:[1,0,0] op_sel_hi:[1,1,1]
  ds_read_b32 v13, v34 offset:50468
  v_dot2_f32_f16 v124, v76, v32, v124
  v_dot2_f32_f16 v125, v77, v32, v125
  v_dot2_f32_f16 v126, v78, v32, v126
  v_dot2_f32_f16 v127, v79, v32, v127
  v_exp_f32 v124, v124
  v_exp_f32 v125, v125
  v_exp_f32 v126, v126
  v_exp_f32 v127, v127
  s_add_u32 s66, s66, 4
  v_pk_add_f32 v[124:125], v[124:125], v[38:39]
  v_pk_add_f32 v[126:127], v[126:127], v[38:39]
  v_rcp_f32 v124, v124
  v_rcp_f32 v125, v125
  v_rcp_f32 v126, v126
  v_rcp_f32 v127, v127
  s_cmp_lg_u32 s66, s70
  v_pk_fma_f32 v[44:45], v[124:125], v[76:77], v[44:45]
  v_pk_fma_f32 v[46:47], v[126:127], v[78:79], v[46:47]
  s_cbranch_scc1 K2_NF6
  s_getpc_b64 s[76:77]
  s_add_u32 s76, s76, 12
  s_addc_u32 s77, s77, 0
  s_branch K2_FLUSH
K2_NF6:
  s_cmp_ge_u32 s66, s67
  s_cbranch_scc1 K2_LOOP_EXIT
  s_waitcnt lgkmcnt(2)
  s_add_u32 s78, s66, 12
  s_cmp_lt_u32 s78, s67
  s_cselect_b32 s38, 12544, 0
  buffer_load_dwordx4 v[76:79], v[50:51], s[36:39], 0 idxen offen
  ds_read_b32 v50, v37 offset:50496
  s_waitcnt vmcnt(3)
  v_pk_fma_f32 v[120:121], v[14:15], v[28:29], v[40:41] op_sel:[0,0,0] op_sel_hi:[0,1,1]
  v_pk_fma_f32 v[122:123], v[14:15], v[30:31], v[42:43] op_sel:[0,0,0] op_sel_hi:[0,1,1]
  ds_read_b32 v14, v34 offset:50500
  v_dot2_f32_f16 v120, v80, v32, v120
  v_dot2_f32_f16 v121, v81, v32, v121
  v_dot2_f32_f16 v122, v82, v32, v122
  v_dot2_f32_f16 v123, v83, v32, v123
  v_exp_f32 v120, v120
  v_exp_f32 v121, v121
  v_exp_f32 v122, v122
  v_exp_f32 v123, v123
  s_add_u32 s66, s66, 4
  v_pk_add_f32 v[120:121], v[120:121], v[38:39]
  v_pk_add_f32 v[122:123], v[122:123], v[38:39]
  v_rcp_f32 v120, v120
  v_rcp_f32 v121, v121
  v_rcp_f32 v122, v122
  v_rcp_f32 v123, v123
  s_cmp_lg_u32 s66, s70
  v_pk_fma_f32 v[44:45], v[120:121], v[80:81], v[44:45]
  v_pk_fma_f32 v[46:47], v[122:123], v[82:83], v[46:47]
  s_cbranch_scc1 K2_NF7
  s_getpc_b64 s[76:77]
  s_add_u32 s76, s76, 12
  s_addc_u32 s77, s77, 0
  s_branch K2_FLUSH
K2_NF7:
  s_cmp_ge_u32 s66, s67
  s_cbranch_scc1 K2_LOOP_EXIT
  s_waitcnt lgkmcnt(2)
  s_add_u32 s78, s66, 12
  s_cmp_lt_u32 s78, s67
  s_cselect_b32 s38, 12544, 0
  buffer_load_dwordx4 v[80:83], v[52:53], s[36:39], 0 idxen offen
  ds_read_b32 v52, v37 offset:50528
  s_waitcnt vmcnt(3)
  v_pk_fma_f32 v[124:125], v[14:15], v[28:29], v[40:41] op_sel:[1,0,0] op_sel_hi:[1,1,1]
  v_pk_fma_f32 v[126:127], v[14:15], v[30:31], v[42:43] op_sel:[1,0,0] op_sel_hi:[1,1,1]
  ds_read_b32 v15, v34 offset:50532
  v_dot2_f32_f16 v124, v84, v32, v124
  v_dot2_f32_f16 v125, v85, v32, v125
  v_dot2_f32_f16 v126, v86, v32, v126
  v_dot2_f32_f16 v127, v87, v32, v127
  v_exp_f32 v124, v124
  v_exp_f32 v125, v125
  v_exp_f32 v126, v126
  v_exp_f32 v127, v127
  s_add_u32 s66, s66, 4
  v_pk_add_f32 v[124:125], v[124:125], v[38:39]
  v_pk_add_f32 v[126:127], v[126:127], v[38:39]
  v_rcp_f32 v124, v124
  v_rcp_f32 v125, v125
  v_rcp_f32 v126, v126
  v_rcp_f32 v127, v127
  s_cmp_lg_u32 s66, s70
  v_pk_fma_f32 v[44:45], v[124:125], v[84:85], v[44:45]
  v_pk_fma_f32 v[46:47], v[126:127], v[86:87], v[46:47]
  s_cbranch_scc1 K2_NF8
  s_getpc_b64 s[76:77]
  s_add_u32 s76, s76, 12
  s_addc_u32 s77, s77, 0
  s_branch K2_FLUSH
K2_NF8:
  s_cmp_ge_u32 s66, s67
  s_cbranch_scc1 K2_LOOP_EXIT
  v_add_u32 v34, 128, v34
  v_add_u32 v37, 128, v37
  s_sub_u32 s78, s67, s66
  s_cmp_gt_u32 s78, 96
  s_cbranch_scc1 K2_PD2
  s_cmp_gt_u32 s78, 48
  s_cbranch_scc1 K2_PA2
  s_cmp_gt_u32 s78, 16
  s_cbranch_scc1 K2_PB2
  s_setprio 0
  s_branch K2_PD2
K2_PA2:
  s_setprio 2
  s_branch K2_PD2
K2_PB2:
  s_setprio 1
K2_PD2:
  s_branch K2_LOOP
K2_LOOP_EXIT:
  s_setprio 0
  v_readlane_b32 s72, v33, s68
  s_cmp_ge_u32 s72, s67
  s_cbranch_scc1 K2_NOFINAL
  s_getpc_b64 s[76:77]
  s_add_u32 s76, s76, 12
  s_addc_u32 s77, s77, 0
  s_branch K2_FLUSH
K2_NOFINAL:
  s_waitcnt vmcnt(0) lgkmcnt(0)
K2_MAIN_DONE:
  v_mov_b32 v11, 512
  ds_read_b32 v34, v11
  s_barrier
  v_lshlrev_b32 v10, 2, v2
  ds_read_b32 v35, v10 offset:576
  ds_read_b32 v11, v10 offset:572
  s_lshl_b32 s71, s5, 8
  v_add_u32 v20, s71, v36
  ds_read_b32 v21, v20 offset:1024
  s_waitcnt lgkmcnt(0)
  v_readfirstlane_b32 s61, v34
  s_min_u32 s61, s61, 3200
  v_cmp_eq_u32 vcc, v35, v11
  v_cmp_ne_u32 s[56:57], -1, v35
  s_and_b64 vcc, vcc, s[56:57]
  s_and_b32 s72, vcc_lo, 0xfffe
  s_cmp_lg_u32 s72, 0
  s_cbranch_scc1 K2_CB_SLOW
  s_cmp_lt_u32 s63, 16
  s_cbranch_scc1 K2_CB_SLOW
  v_readlane_b32 s72, v35, s5
  s_cmp_eq_u32 s72, -1
  s_cbranch_scc1 K2_CB_F1
  s_lshl_b32 s72, s72, 8
  v_add_u32 v20, s72, v36
  ds_read_b32 v22, v20 offset:5120
  s_waitcnt lgkmcnt(0)
  v_add_f32 v22, v22, v21
  ds_write_b32 v20, v22 offset:5120
  s_waitcnt lgkmcnt(0)
K2_CB_F1:
  s_barrier
  ds_read_b128 v[12:15], v3 offset:5120
  ds_read_b128 v[16:19], v3 offset:34048
  s_waitcnt lgkmcnt(0)
  s_branch K2_CB_DONE
K2_CB_SLOW:
  ds_read_b128 v[12:15], v3 offset:5120
  ds_read_b128 v[16:19], v3 offset:34048
  v_lshrrev_b32 v10, 4, v0
  s_waitcnt lgkmcnt(0)
  v_readlane_b32 s72, v35, 0
  s_nop 1
  v_cmpx_eq_u32 vcc, s72, v10
  s_cbranch_execz K2_CB0
  ds_read_b128 v[20:23], v6 offset:1024
  s_waitcnt lgkmcnt(0)
  v_add_f32 v12, v12, v20
  v_add_f32 v13, v13, v21
  v_add_f32 v14, v14, v22
  v_add_f32 v15, v15, v23
K2_CB0:
  s_mov_b64 exec, -1
  v_readlane_b32 s72, v35, 1
  s_nop 1
  v_cmpx_eq_u32 vcc, s72, v10
  s_cbranch_execz K2_CB1
  ds_read_b128 v[20:23], v6 offset:1280
  s_waitcnt lgkmcnt(0)
  v_add_f32 v12, v12, v20
  v_add_f32 v13, v13, v21
  v_add_f32 v14, v14, v22
  v_add_f32 v15, v15, v23
K2_CB1:
  s_mov_b64 exec, -1
  v_readlane_b32 s72, v35, 2
  s_nop 1
  v_cmpx_eq_u32 vcc, s72, v10
  s_cbranch_execz K2_CB2
  ds_read_b128 v[20:23], v6 offset:1536
  s_waitcnt lgkmcnt(0)
  v_add_f32 v12, v12, v20
  v_add_f32 v13, v13, v21
  v_add_f32 v14, v14, v22
  v_add_f32 v15, v15, v23
K2_CB2:
  s_mov_b64 exec, -1
  v_readlane_b32 s72, v35, 3
  s_nop 1
  v_cmpx_eq_u32 vcc, s72, v10
  s_cbranch_execz K2_CB3
  ds_read_b128 v[20:23], v6 offset:1792
  s_waitcnt lgkmcnt(0)
  v_add_f32 v12, v12, v20
  v_add_f32 v13, v13, v21
  v_add_f32 v14, v14, v22
  v_add_f32 v15, v15, v23
K2_CB3:
  s_mov_b64 exec, -1
  v_readlane_b32 s72, v35, 4
  s_nop 1
  v_cmpx_eq_u32 vcc, s72, v10
  s_cbranch_execz K2_CB4
  ds_read_b128 v[20:23], v6 offset:2048
  s_waitcnt lgkmcnt(0)
  v_add_f32 v12, v12, v20
  v_add_f32 v13, v13, v21
  v_add_f32 v14, v14, v22
  v_add_f32 v15, v15, v23
K2_CB4:
  s_mov_b64 exec, -1
  v_readlane_b32 s72, v35, 5
  s_nop 1
  v_cmpx_eq_u32 vcc, s72, v10
  s_cbranch_execz K2_CB5
  ds_read_b128 v[20:23], v6 offset:2304
  s_waitcnt lgkmcnt(0)
  v_add_f32 v12, v12, v20
  v_add_f32 v13, v13, v21
  v_add_f32 v14, v14, v22
  v_add_f32 v15, v15, v23
K2_CB5:
  s_mov_b64 exec, -1
  v_readlane_b32 s72, v35, 6
  s_nop 1
  v_cmpx_eq_u32 vcc, s72, v10
  s_cbranch_execz K2_CB6
  ds_read_b128 v[20:23], v6 offset:2560
  s_waitcnt lgkmcnt(0)
  v_add_f32 v12, v12, v20
  v_add_f32 v13, v13, v21
  v_add_f32 v14, v14, v22
  v_add_f32 v15, v15, v23
K2_CB6:
  s_mov_b64 exec, -1
  v_readlane_b32 s72, v35, 7
  s_nop 1
  v_cmpx_eq_u32 vcc, s72, v10
  s_cbranch_execz K2_CB7
  ds_read_b128 v[20:23], v6 offset:2816
  s_waitcnt lgkmcnt(0)
  v_add_f32 v12, v12, v20
  v_add_f32 v13, v13, v21
  v_add_f32 v14, v14, v22
  v_add_f32 v15, v15, v23
K2_CB7:
  s_mov_b64 exec, -1
  v_readlane_b32 s72, v35, 8
  s_nop 1
  v_cmpx_eq_u32 vcc, s72, v10
  s_cbranch_execz K2_CB8
  ds_read_b128 v[20:23], v6 offset:3072
  s_waitcnt lgkmcnt(0)
  v_add_f32 v12, v12, v20
  v_add_f32 v13, v13, v21
  v_add_f32 v14, v14, v22
  v_add_f32 v15, v15, v23
K2_CB8:
  s_mov_b64 exec, -1
  v_readlane_b32 s72, v35, 9
  s_nop 1
  v_cmpx_eq_u32 vcc, s72, v10
  s_cbranch_execz K2_CB9
  ds_read_b128 v[20:23], v6 offset:3328
  s_waitcnt lgkmcnt(0)
  v_add_f32 v12, v12, v20
  v_add_f32 v13, v13, v21
  v_add_f32 v14, v14, v22
  v_add_f32 v15, v15, v23
K2_CB9:
  s_mov_b64 exec, -1
  v_readlane_b32 s72, v35, 10
  s_nop 1
  v_cmpx_eq_u32 vcc, s72, v10
  s_cbranch_execz K2_CB10
  ds_read_b128 v[20:23], v6 offset:3584
  s_waitcnt lgkmcnt(0)
  v_add_f32 v12, v12, v20
  v_add_f32 v13, v13, v21
  v_add_f32 v14, v14, v22
  v_add_f32 v15, v15, v23
K2_CB10:
  s_mov_b64 exec, -1
  v_readlane_b32 s72, v35, 11
  s_nop 1
  v_cmpx_eq_u32 vcc, s72, v10
  s_cbranch_execz K2_CB11
  ds_read_b128 v[20:23], v6 offset:3840
  s_waitcnt lgkmcnt(0)
  v_add_f32 v12, v12, v20
  v_add_f32 v13, v13, v21
  v_add_f32 v14, v14, v22
  v_add_f32 v15, v15, v23
K2_CB11:
  s_mov_b64 exec, -1
  v_readlane_b32 s72, v35, 12
  s_nop 1
  v_cmpx_eq_u32 vcc, s72, v10
  s_cbranch_execz K2_CB12
  ds_read_b128 v[20:23], v6 offset:4096
  s_waitcnt lgkmcnt(0)
  v_add_f32 v12, v12, v20
  v_add_f32 v13, v13, v21
  v_add_f32 v14, v14, v22
  v_add_f32 v15, v15, v23
K2_CB12:
  s_mov_b64 exec, -1
  v_readlane_b32 s72, v35, 13
  s_nop 1
  v_cmpx_eq_u32 vcc, s72, v10
  s_cbranch_execz K2_CB13
  ds_read_b128 v[20:23], v6 offset:4352
  s_waitcnt lgkmcnt(0)
  v_add_f32 v12, v12, v20
  v_add_f32 v13, v13, v21
  v_add_f32 v14, v14, v22
  v_add_f32 v15, v15, v23
K2_CB13:
  s_mov_b64 exec, -1
  v_readlane_b32 s72, v35, 14
  s_nop 1
  v_cmpx_eq_u32 vcc, s72, v10
  s_cbranch_execz K2_CB14
  ds_read_b128 v[20:23], v6 offset:4608
  s_waitcnt lgkmcnt(0)
  v_add_f32 v12, v12, v20
  v_add_f32 v13, v13, v21
  v_add_f32 v14, v14, v22
  v_add_f32 v15, v15, v23
K2_CB14:
  s_mov_b64 exec, -1
  v_readlane_b32 s72, v35, 15
  s_nop 1
  v_cmpx_eq_u32 vcc, s72, v10
  s_cbranch_execz K2_CB15
  ds_read_b128 v[20:23], v6 offset:4864
  s_waitcnt lgkmcnt(0)
  v_add_f32 v12, v12, v20
  v_add_f32 v13, v13, v21
  v_add_f32 v14, v14, v22
  v_add_f32 v15, v15, v23
K2_CB15:
  s_mov_b64 exec, -1
K2_CB_DONE:
  s_add_u32 s60, s60, 48
  s_cmp_ge_u32 s60, s61
  s_cbranch_scc1 K2_FINAL
  v_cmp_gt_u32 vcc, 784, v0
  s_and_saveexec_b64 s[56:57], vcc
  s_cbranch_execz K2_NR0
  ds_write_b128 v3, v[12:15] offset:5120
K2_NR0:
  s_mov_b64 exec, s[56:57]
  s_cmp_lg_u32 s5, 0
  s_cbranch_scc1 K2_NR1
  v_lshlrev_b32 v11, 2, v2
  v_mov_b32 v34, 0
  ds_write_b32 v11, v34 offset:0
K2_NR1:
  v_subrev_u32 v26, 48, v26
  v_subrev_u32 v25, 48, v25
  v_add_u32 v8, 384, v8
  v_add_u32 v24, 384, v24
  s_branch K2_ROUND
K2_FINAL:
  v_cmp_gt_u32 vcc, 784, v0
  s_and_saveexec_b64 s[56:57], vcc
  s_cbranch_execz K2_FIN2
  v_lshlrev_b32 v11, 3, v0
  s_mul_i32 s6, s2, 6272
  v_add_f32 v12, v12, v16
  v_add_f32 v13, v13, v17
  v_add_f32 v14, v14, v18
  v_add_f32 v15, v15, v19
  v_mul_f32 v20, 0xbfb8aa3b, v12
  v_mul_f32 v21, 0xbfb8aa3b, v13
  v_mul_f32 v22, 0xbfb8aa3b, v14
  v_mul_f32 v23, 0xbfb8aa3b, v15
  v_exp_f32 v20, v20
  v_exp_f32 v21, v21
  v_exp_f32 v22, v22
  v_exp_f32 v23, v23
  v_add_f32 v20, 1.0, v20
  v_add_f32 v21, 1.0, v21
  v_add_f32 v22, 1.0, v22
  v_add_f32 v23, 1.0, v23
  v_rcp_f32 v20, v20
  v_rcp_f32 v21, v21
  v_rcp_f32 v22, v22
  v_rcp_f32 v23, v23
  s_nop 0
  v_mul_f32 v12, v12, v20
  v_mul_f32 v13, v13, v21
  v_mul_f32 v14, v14, v22
  v_mul_f32 v15, v15, v23
  v_cvt_pk_bf16_f32 v12, v12, v13
  v_cvt_pk_bf16_f32 v13, v14, v15
  buffer_store_dwordx2 v[12:13], v11, s[52:55], s6 offen
K2_FIN2:
  s_mov_b64 exec, -1
K2_END:
  s_endpgm
K2_FLUSH:
  s_nop 1
  v_permlane32_swap_b32 v44, v45
  v_permlane32_swap_b32 v46, v47
  s_lshl_b32 s71, s68, 8
  v_add_u32 v35, s71, v6
  v_add_f32 v44, v44, v45
  v_add_f32 v46, v46, v47
  ds_read_b128 v[40:43], v35 offset:17920
  v_add_u32 v35, s71, v36
  v_permlane16_swap_b32 v44, v46
  s_cmp_lg_u32 s73, 0
  s_cbranch_scc1 K2_FL_HEAD
  v_add_f32 v44, v44, v46
  s_cmp_eq_u32 s60, 0
  s_cbranch_scc1 K2_FL_W
  ds_read_b32 v45, v35 offset:5120
  s_waitcnt lgkmcnt(0)
  v_add_f32 v44, v44, v45
K2_FL_W:
  ds_write_b32 v35, v44 offset:5120
  s_branch K2_FL_C
K2_FL_HEAD:
  v_add_f32 v44, v44, v46
  s_lshl_b32 s71, s5, 8
  v_add_u32 v35, s71, v36
  ds_write_b32 v35, v44 offset:1024
  s_mov_b32 s73, 0
K2_FL_C:
  s_add_u32 s68, s68, 1
  s_add_u32 s69, s68, 1
  v_readlane_b32 s70, v33, s69
  s_waitcnt lgkmcnt(0)
  s_cmp_eq_u32 s75, 0
  s_cbranch_scc1 K2_FL_S
  v_exp_f32 v40, v40
  v_exp_f32 v41, v41
  v_exp_f32 v42, v42
  v_exp_f32 v43, v43
K2_FL_S:
  v_mov_b32 v44, 0
  v_mov_b32 v45, 0
  v_mov_b32 v46, 0
  v_mov_b32 v47, 0
  s_setpc_b64 s[76:77]
.section .rodata,"a"
.p2align 6
.amdhsa_kernel mpnn_k1_kernel
  .amdhsa_next_free_vgpr 112
  .amdhsa_next_free_sgpr 102
  .amdhsa_accum_offset 112
  .amdhsa_group_segment_fixed_size 0
  .amdhsa_kernarg_size 80
  .amdhsa_user_sgpr_count 2
  .amdhsa_user_sgpr_kernarg_segment_ptr 1
  .amdhsa_system_sgpr_workgroup_id_x 1
.end_amdhsa_kernel
.p2align 6
.amdhsa_kernel mpnn_k2_kernel
  .amdhsa_next_free_vgpr 128
  .amdhsa_next_free_sgpr 102
  .amdhsa_accum_offset 128
  .amdhsa_group_segment_fixed_size 0
  .amdhsa_kernarg_size 80
  .amdhsa_user_sgpr_count 2
  .amdhsa_user_sgpr_kernarg_segment_ptr 1
  .amdhsa_system_sgpr_workgroup_id_x 1
.end_amdhsa_kernel
```
